```python
import torch

def _softmax(x, axis=-1):
    return torch.softmax(x, dim=axis)
def _gelu(x):
    return torch.nn.functional.gelu(x, approximate="tanh")
def _silu(x):
    return torch.nn.functional.silu(x)
def _sigmoid(x):
    return torch.sigmoid(x)
def _layernorm(x, axis=-1, eps=1e-5):
    m = x.mean(dim=axis, keepdim=True)
    v = x.var(dim=axis, keepdim=True, unbiased=False)
    return (x - m) / torch.sqrt(v + eps)
def _scatter_add(tgt, idx, src, axis=0):
    return tgt.clone().index_add_(axis, idx, src)
def _segment_sum(src, seg, n):
    out = torch.zeros((n,) + src.shape[1:], dtype=src.dtype)
    return out.index_add_(0, seg, src)
def _pad(x, pw):
    flat = tuple(v for pair in reversed(pw) for v in pair)
    return torch.nn.functional.pad(x, flat)

kernel_name = 'sequential_preLN__sliding_block_cached__glu_gated_reglu__decode'

def setup_inputs():

    _w = (lambda a: (lambda t: t.to(torch.bfloat16) if t.is_floating_point() else t)(torch.as_tensor(a)))
    def _A_setup():
        B, Sq, D = 1, 1, 512
        Hq, Hkv, Sk, Dh = 32, 32, 32768, 128
        assert Hq % Hkv == 0, (Hq, Hkv)
        return {
            "x": _w((lambda *s: torch.randn(*s, dtype=torch.bfloat16) * 0.05)(B, Sq, D)),
            "k_cache": _w((lambda *s: torch.randn(*s, dtype=torch.bfloat16) * 1.6)(B, Hkv, Sk, Dh)),
            "v_cache": _w((lambda *s: torch.randn(*s, dtype=torch.bfloat16) * 0.8)(B, Hkv, Sk, Dh)),
            "wq": _w((lambda *s: torch.randn(*s, dtype=torch.bfloat16) * 1.6)(D, Hq * Dh) * (D ** -0.5)),
            "wo": _w((lambda *s: torch.randn(*s, dtype=torch.bfloat16) * 0.8)(Hq * Dh, D) * ((Hq * Dh) ** -0.5)),
        }
    _A_in = _A_setup()

    def _B_setup():
        B, S, D, F = 1, 1, 512, 1376
        return {
            "x": _w((lambda *s: torch.randn(*s, dtype=torch.bfloat16) * 0.05)(B, S, D)),
            "W_gate": _w((lambda *s: torch.randn(*s, dtype=torch.bfloat16) * 0.4)(D, F) * (2.0 / D) ** 0.5),
            "W_up": _w((lambda *s: torch.randn(*s, dtype=torch.bfloat16) * 0.4)(D, F) * (2.0 / D) ** 0.5),
            "W_down": _w((lambda *s: torch.randn(*s, dtype=torch.bfloat16) * 0.4)(F, D) * (1.0 / F) ** 0.5),
        }
    _B_in = _B_setup()

    return {
        "A_x": _A_in["x"],
        "A_k_cache": _A_in["k_cache"],
        "A_v_cache": _A_in["v_cache"],
        "A_wq": _A_in["wq"],
        "A_wo": _A_in["wo"],
        "B_x": _B_in["x"],
        "B_W_gate": _B_in["W_gate"],
        "B_W_up": _B_in["W_up"],
        "B_W_down": _B_in["W_down"],
    }

def reference(A_x, A_k_cache, A_v_cache, A_wq, A_wo, B_x, B_W_gate, B_W_up, B_W_down):
    def _A_ref(x, k_cache, v_cache, wq, wo):
        B, Sq, D = x.shape
        Hq, Dh = 32, 128
        Hkv, Sk = k_cache.shape[1], k_cache.shape[2]
        W = min(4096, max(256, Sk // 4))
        rep = Hq // Hkv
        q = (lambda x, *d: x.permute(*d))((x @ wq).reshape(B, Sq, Hq, Dh), 0, 2, 1, 3)
        k = (lambda x, n, axis: torch.repeat_interleave(x, n, dim=axis))(k_cache[:, :, Sk - W:, :], rep, axis=1)
        v = (lambda x, n, axis: torch.repeat_interleave(x, n, dim=axis))(v_cache[:, :, Sk - W:, :], rep, axis=1)
        scores = torch.einsum("bhqd,bhkd->bhqk", q, k) * (Dh ** -0.5)
        p = _softmax(scores, axis=-1)
        o = torch.einsum("bhqk,bhkd->bhqd", p, v)
        return (lambda x, *d: x.permute(*d))(o, 0, 2, 1, 3).reshape(B, Sq, Hq * Dh) @ wo

    def _B_ref(x, W_gate, W_up, W_down):
        gate = torch.einsum("bsd,df->bsf", x, W_gate)
        up = torch.einsum("bsd,df->bsf", x, W_up)
        gate = gate * (lambda x, dt: x.to(dt))(gate > 0, gate.dtype)
        h = gate * up
        return torch.einsum("bsf,fd->bsd", h, W_down)

    x = A_x
    h = x + _A_ref(_layernorm(x, axis=-1), A_k_cache, A_v_cache, A_wq, A_wo)
    h2 = h + _B_ref(_layernorm(h, axis=-1), B_W_gate, B_W_up, B_W_down)
    return h2
```

```asm
; @launch grid=(256,1,1) block=(512,1,1) lds=67584
.amdgcn_target "amdgcn-amd-amdhsa--gfx950"
.text
.globl sequential_preLN__sliding_block_cached__glu_gated_reglu__decode_kernel
.p2align 8
.type sequential_preLN__sliding_block_cached__glu_gated_reglu__decode_kernel,@function
sequential_preLN__sliding_block_cached__glu_gated_reglu__decode_kernel:
    s_load_dwordx8 s[4:11], s[0:1], 0
    s_load_dwordx16 s[12:27], s[0:1], 32
    s_cmp_ge_u32 s2, 256
    s_cbranch_scc1 EXIT
    s_and_b32 s28, s2, 7
    s_lshr_b32 s29, s2, 3
    s_lshr_b32 s33, s29, 3
    s_lshl2_add_u32 s30, s28, s33
    s_and_b32 s31, s29, 7
    v_lshrrev_b32 v1, 6, v0
    v_and_b32 v0, 63, v0
    v_readfirstlane_b32 s32, v1
    v_lshrrev_b32 v10, 4, v0
    v_and_b32 v11, 15, v0
    v_lshlrev_b32 v12, 4, v0
    v_lshlrev_b32 v13, 16, v1
    v_lshl_add_u32 v13, v10, 13, v13
    v_lshl_add_u32 v13, v11, 4, v13
    s_lshl_b32 s33, s31, 6
    v_and_b32 v14, 1, v11
    v_lshl_add_u32 v14, v14, 2, v10
    v_lshl_add_u32 v14, v1, 3, v14
    v_add_lshl_u32 v14, v14, s33, 1
    s_lshl_b32 s40, s31, 19
    v_lshlrev_b32 v4, 14, v1
    v_bfe_u32 v2, v0, 2, 2
    v_lshl_add_u32 v2, v2, 8, v4
    v_lshl_add_u32 v2, v10, 6, v2
    v_and_b32 v3, 3, v0
    v_lshl_add_u32 v2, v3, 4, v2
    v_add_u32 v4, v12, v4
    s_mul_i32 s56, s32, 1
    s_mul_i32 s33, s31, 3
    s_add_u32 s56, s56, s33
    s_mul_i32 s33, s30, 5
    s_add_u32 s56, s56, s33
    s_and_b32 s56, s56, 15
    s_lshl_b32 s56, s56, 10
    s_mov_b32 s57, s56
    s_mov_b32 s50, 0x20000
    s_mov_b32 s51, 0x20000
    s_mov_b32 s54, 0x20000
    s_mov_b32 s55, 0x20000
    s_lshl_b32 s42, s30, 23
    s_lshl_b32 s43, s31, 17
    s_add_u32 s42, s42, s43
    s_add_u32 s42, s42, 0x700000
    s_lshl_b32 s33, s30, 8
    s_mov_b32 s38, 0x400000
    s_mov_b32 s39, 0x20000
    s_sub_u32 s38, s38, s33
    s_mov_b32 s41, 0
    s_waitcnt lgkmcnt(0)
    s_add_u32 s36, s10, s33
    s_addc_u32 s37, s11, 0
    global_load_dwordx4 v[16:19], v12, s[4:5]
    s_load_dword s59, s[26:27], 524032
    global_load_short_d16_hi v15, v14, s[4:5]
    s_add_u32 s48, s6, s42
    s_addc_u32 s49, s7, 0
    s_add_u32 s52, s8, s42
    s_addc_u32 s53, s9, 0
    buffer_load_dwordx4 v[160:163], v13, s[36:39], s40 offen nt
    s_add_u32 s40, s40, 0x8000
    buffer_load_dwordx4 v[164:167], v13, s[36:39], s40 offen nt
    buffer_load_dwordx4 v[32:35], v2, s[48:51], s56 offen nt
    s_add_u32 s56, s56, 0x400
    s_and_b32 s56, s56, 0x3fff
    buffer_load_dwordx4 v[36:39], v2, s[48:51], s56 offen nt
    s_add_u32 s56, s56, 0x400
    s_and_b32 s56, s56, 0x3fff
    s_mov_b32 s34, 0
    s_and_b32 s35, s29, 15
    s_cmp_lt_u32 s29, 16
    s_cselect_b32 s34, 1, s34
    s_mul_i32 s33, s28, 11
    s_add_u32 s33, s33, s35
    s_sub_u32 s42, s29, 16
    s_cmp_lt_u32 s42, 11
    s_cselect_b32 s33, s33, 99
    s_cmp_lt_u32 s33, 86
    s_cselect_b32 s34, 2, s34
    s_cselect_b32 s35, s33, s35
    s_and_b32 s33, s29, 3
    s_lshl2_add_u32 s33, s28, s33
    s_cmp_ge_u32 s29, 28
    s_cselect_b32 s34, 3, s34
    s_cselect_b32 s35, s33, s35
    s_mov_b32 s45, 0
    s_getreg_b32 s47, hwreg(HW_REG_XCC_ID, 0, 4)
    s_lshl_b32 s47, s47, 8
    v_and_b32 v20, 1, v0
    v_lshlrev_b32 v20, 4, v20
    v_mov_b32 v21, 0xffff
    v_lshlrev_b32 v20, v20, v21
    v_bfe_u32 v21, v0, 1, 2
    v_cmp_eq_u32 vcc, 0, v21
    s_nop 1
    v_cndmask_b32 v240, 0, v20, vcc
    v_cmp_eq_u32 vcc, 1, v21
    s_nop 1
    v_cndmask_b32 v241, 0, v20, vcc
    v_cmp_eq_u32 vcc, 2, v21
    s_nop 1
    v_cndmask_b32 v242, 0, v20, vcc
    v_cmp_eq_u32 vcc, 3, v21
    s_nop 1
    v_cndmask_b32 v243, 0, v20, vcc
    s_lshl3_add_u32 s33, s30, s31
    s_mul_i32 s46, s33, 640
    v_add_u32 v24, s46, v12
    s_lshl_b32 s33, s33, 10
    s_add_u32 s33, s33, 786432
    v_add_u32 v5, s33, v12
    s_lshl3_add_u32 s33, s30, s32
    s_lshl_b32 s33, s33, 10
    s_add_u32 s33, s33, 786432
    v_add_u32 v14, s33, v12
    v_lshlrev_b32 v25, 2, v0
    v_lshlrev_b32 v26, 9, v1
    v_lshl_add_u32 v26, v11, 5, v26
    v_lshl_add_u32 v26, v10, 4, v26
    v_lshlrev_b32 v27, 2, v1
    v_lshl_add_u32 v27, v11, 5, v27
    v_add_u32 v27, 15616, v27
    v_mov_b32 v28, v12
    s_mul_i32 s33, s32, 384
    s_add_u32 s33, s33, 12544
    v_lshl_add_u32 v8, v0, 1, s33
    v_lshl_add_u32 v9, v10, 4, s33
    v_lshrrev_b32 v20, 2, v0
    v_and_b32 v21, 3, v0
    v_and_b32 v22, 3, v20
    v_lshl_add_u32 v22, v10, 3, v22
    v_lshl_add_u32 v23, v1, 6, v20
    v_and_b32 v29, 7, v0
    s_lshr_b32 s33, s32, 1
    s_lshl2_add_u32 s33, s28, s33
    s_mul_i32 s33, s33, 5120
    v_mul_u32_u24 v30, 640, v29
    v_add_u32 v30, s33, v30
    v_mov_b32 v7, 0
    s_cmp_eq_u32 s34, 2
    s_cbranch_scc1 ADDR_C
    s_cmp_eq_u32 s34, 3
    s_cbranch_scc1 ADDR_D
    s_and_b32 s42, s32, 1
    s_lshl_b32 s42, s42, 8
    s_add_u32 s33, s33, s42
    s_add_u32 s33, s33, 2560
    v_add_u32 v29, s33, v25
    s_lshl_b32 s33, s28, 19
    s_lshl_b32 s42, s35, 6
    s_add_u32 s33, s33, s42
    v_lshl_add_u32 v6, v23, 10, s33
    v_lshl_add_u32 v6, v21, 4, v6
    v_lshl_add_u64 v[6:7], v[6:7], 0, s[12:13]
    s_mov_b32 s44, 0x4000
    s_lshl_b32 s33, s35, 6
    s_add_u32 s33, s33, s28
    s_lshl_b32 s33, s33, 7
    s_add_u32 s33, s33, 1314816
    v_and_b32 v28, 31, v0
    v_lshl_add_u32 v31, v28, 2, s33
    v_lshrrev_b32 v20, 5, v0
    v_lshl_add_u32 v31, v20, 10, v31
    v_lshlrev_b32 v28, 5, v28
    v_lshlrev_b32 v22, 6, v22
    s_branch ADDR_W
ADDR_C:
    v_mul_u32_u24 v6, 2752, v23
    v_and_b32 v29, 1, v0
    v_lshl_add_u32 v6, v29, 4, v6
    s_lshl_b32 s33, s35, 5
    v_add_u32 v6, s33, v6
    v_cmp_gt_u32 vcc, 2, v21
    v_mov_b32 v208, s16
    v_mov_b32 v209, s17
    v_mov_b32 v29, s18
    v_mov_b32 v31, s19
    v_cndmask_b32 v208, v29, v208, vcc
    v_cndmask_b32 v209, v31, v209, vcc
    v_lshl_add_u64 v[6:7], v[6:7], 0, v[208:209]
    s_mov_b32 s44, 44032
    v_and_b32 v28, 31, v0
    v_lshrrev_b32 v20, 5, v0
    v_lshl_add_u32 v20, v1, 1, v20
    s_and_b32 s33, s28, 7
    s_lshl_b32 s33, s33, 10
    s_add_u32 s33, s33, 1310720
    v_lshl_add_u32 v29, v20, 13, s33
    v_lshl_add_u32 v29, v28, 2, v29
    v_lshlrev_b32 v28, 5, v28
    s_lshl_b32 s33, s35, 7
    s_add_u32 s33, s33, 1572864
    v_lshl_add_u32 v31, v11, 2, s33
    v_lshrrev_b32 v20, 4, v0
    v_lshl_add_u32 v31, v20, 14, v31
    v_lshlrev_b32 v22, 6, v22
    s_branch ADDR_W
ADDR_D:
    v_lshrrev_b32 v20, 1, v0
    v_lshl_add_u32 v6, v1, 5, v20
    v_and_b32 v29, 1, v0
    v_lshlrev_b32 v6, 10, v6
    v_lshl_add_u32 v6, v29, 4, v6
    s_lshl_b32 s33, s35, 5
    v_add_u32 v6, s33, v6
    v_lshl_add_u64 v[6:7], v[6:7], 0, s[20:21]
    s_mov_b32 s44, 0x40000
    v_and_b32 v20, 15, v20
    v_lshl_add_u32 v31, v20, 1, s33
    s_lshr_b32 s33, s35, 1
    s_lshl_b32 s33, s33, 3
    s_and_b32 s42, s28, 7
    s_add_u32 s33, s33, s42
    s_and_b32 s42, s35, 1
    s_lshl4_add_u32 s33, s33, s42
    s_lshl_b32 s33, s33, 6
    s_add_u32 s33, s33, 1310720
    v_lshl_add_u32 v29, v20, 2, s33
    v_lshlrev_b32 v22, 5, v22
ADDR_W:
    s_mul_i32 s33, s32, 6144
    s_add_u32 s33, s33, 18432
    v_lshl_add_u32 v22, v21, 3, v22
    v_add_u32 v216, s33, v22
    v_add_u32 v217, s33, v12
ADDR_DONE:
    s_lshl3_add_u32 s33, s29, s32
    s_lshl_b32 s42, s28, 8
    s_add_u32 s42, s42, s33
    s_lshl_b32 s42, s42, 11
    v_lshrrev_b32 v20, 2, v0
    v_lshl_add_u32 v218, v20, 7, s42
    s_and_b32 s33, s33, 127
    v_lshrrev_b32 v20, 2, v0
    v_lshl_add_u32 v220, v20, 7, s33
    v_min_u32 v220, 1375, v220
    s_lshl_b32 s42, s28, 7
    v_lshl_add_u32 v220, v220, 10, s42
    v_and_b32 v20, 3, v20
    v_lshlrev_b32 v20, 7, v20
    v_min_u32 v20, 348, v20
    s_mul_i32 s42, s28, 352
    v_add_u32 v20, s42, v20
    v_min_u32 v20, 2748, v20
    v_lshrrev_b32 v219, 4, v0
    s_lshl_b32 s33, s33, 2
    v_add_u32 v219, s33, v219
    v_mul_u32_u24 v219, 2752, v219
    v_add_u32 v219, v20, v219
    s_waitcnt lgkmcnt(0)
    s_add_u32 s59, s59, 1
    s_mov_b32 s58, 0xff
    s_and_b32 s33, s59, s58
    v_mov_b32 v3, s33
    s_waitcnt vmcnt(4)
    v_lshlrev_b32 v224, 16, v16
    v_and_b32 v225, 0xffff0000, v16
    v_lshlrev_b32 v226, 16, v17
    v_and_b32 v227, 0xffff0000, v17
    v_lshlrev_b32 v228, 16, v18
    v_and_b32 v229, 0xffff0000, v18
    v_lshlrev_b32 v230, 16, v19
    v_and_b32 v231, 0xffff0000, v19
    v_and_b32 v15, 0xffff0000, v15
    v_add_f32 v232, v224, v225
    v_add_f32 v233, v226, v227
    v_add_f32 v234, v228, v229
    v_add_f32 v232, v232, v233
    v_add_f32 v233, v230, v231
    v_add_f32 v234, v234, v233
    v_add_f32 v234, v234, v232
    s_nop 1
    v_add_f32_dpp v234, v234, v234 row_ror:8 row_mask:0xf bank_mask:0xf
    s_nop 1
    v_add_f32_dpp v234, v234, v234 row_ror:4 row_mask:0xf bank_mask:0xf
    s_nop 1
    v_add_f32_dpp v234, v234, v234 row_ror:2 row_mask:0xf bank_mask:0xf
    s_nop 1
    v_add_f32_dpp v234, v234, v234 row_ror:1 row_mask:0xf bank_mask:0xf
    v_mov_b32 v233, v234
    s_nop 1
    v_permlane16_swap_b32 v233, v234
    v_add_f32 v234, v234, v233
    v_mov_b32 v233, v234
    s_nop 1
    v_permlane32_swap_b32 v233, v234
    v_add_f32 v234, v234, v233
    v_mul_f32 v234, 0x3b000000, v234
    v_sub_f32 v224, v224, v234
    v_sub_f32 v225, v225, v234
    v_sub_f32 v226, v226, v234
    v_sub_f32 v227, v227, v234
    v_sub_f32 v228, v228, v234
    v_sub_f32 v229, v229, v234
    v_sub_f32 v230, v230, v234
    v_sub_f32 v231, v231, v234
    v_mul_f32 v232, v224, v224
    v_mul_f32 v233, v225, v225
    v_fmac_f32 v232, v226, v226
    v_fmac_f32 v233, v227, v227
    v_fmac_f32 v232, v228, v228
    v_fmac_f32 v233, v229, v229
    v_fmac_f32 v232, v230, v230
    v_fmac_f32 v233, v231, v231
    v_add_f32 v232, v232, v233
    v_cvt_pk_bf16_f32 v234, v234, v234
    v_and_b32 v234, 0xffff0000, v234
    v_sub_f32 v15, v15, v234
    v_cvt_pk_bf16_f32 v15, v15, v15
    v_and_b32 v15, 0xffff0000, v15
    s_nop 1
    v_add_f32_dpp v232, v232, v232 row_ror:8 row_mask:0xf bank_mask:0xf
    s_nop 1
    v_add_f32_dpp v232, v232, v232 row_ror:4 row_mask:0xf bank_mask:0xf
    s_nop 1
    v_add_f32_dpp v232, v232, v232 row_ror:2 row_mask:0xf bank_mask:0xf
    s_nop 1
    v_add_f32_dpp v232, v232, v232 row_ror:1 row_mask:0xf bank_mask:0xf
    v_mov_b32 v233, v232
    s_nop 1
    v_permlane16_swap_b32 v233, v232
    v_add_f32 v232, v232, v233
    v_mov_b32 v233, v232
    s_nop 1
    v_permlane32_swap_b32 v233, v232
    v_add_f32 v232, v232, v233
    v_mul_f32 v232, 0x3b000000, v232
    v_cvt_pk_bf16_f32 v232, v232, v232
    v_and_b32 v232, 0xffff0000, v232
    v_add_f32 v232, 0x3727c5ac, v232
    v_cvt_pk_bf16_f32 v232, v232, v232
    v_and_b32 v232, 0xffff0000, v232
    v_sqrt_f32 v232, v232
    s_nop 0
    v_cvt_pk_bf16_f32 v232, v232, v232
    v_and_b32 v232, 0xffff0000, v232
    v_rcp_f32 v232, v232
    s_nop 0
    v_mul_f32 v15, v15, v232
    v_cvt_pk_bf16_f32 v15, v15, v15
    s_nop 1
    v_and_b32_dpp v224, v15, v240 row_newbcast:0 row_mask:0xf bank_mask:0xf
    v_and_b32_dpp v225, v15, v241 row_newbcast:0 row_mask:0xf bank_mask:0xf
    v_and_b32_dpp v226, v15, v242 row_newbcast:0 row_mask:0xf bank_mask:0xf
    v_and_b32_dpp v227, v15, v243 row_newbcast:0 row_mask:0xf bank_mask:0xf
    v_and_b32_dpp v228, v15, v240 row_newbcast:1 row_mask:0xf bank_mask:0xf
    v_and_b32_dpp v229, v15, v241 row_newbcast:1 row_mask:0xf bank_mask:0xf
    v_and_b32_dpp v230, v15, v242 row_newbcast:1 row_mask:0xf bank_mask:0xf
    v_and_b32_dpp v231, v15, v243 row_newbcast:1 row_mask:0xf bank_mask:0xf
    buffer_load_dwordx4 v[40:43], v2, s[48:51], s56 offen nt
    s_add_u32 s56, s56, 0x400
    s_and_b32 s56, s56, 0x3fff
    buffer_load_dwordx4 v[44:47], v2, s[48:51], s56 offen nt
    s_add_u32 s56, s56, 0x400
    s_and_b32 s56, s56, 0x3fff
    s_waitcnt vmcnt(5)
    v_mfma_f32_16x16x32_bf16 v[244:247], v[224:227], v[160:163], 0
    s_nop 1
    buffer_load_dwordx4 v[48:51], v2, s[48:51], s56 offen nt
    s_add_u32 s56, s56, 0x400
    s_and_b32 s56, s56, 0x3fff
    s_waitcnt vmcnt(5)
    v_mfma_f32_16x16x32_bf16 v[244:247], v[228:231], v[164:167], v[244:247]
    s_nop 7
    s_mov_b32 exec_hi, 0
    ds_write_b128 v26, v[244:247] offset:8448
    s_mov_b32 exec_hi, -1
    s_waitcnt lgkmcnt(0)
    s_barrier
    s_cmp_lg_u32 s32, 0
    s_cbranch_scc1 NO_QPUB
    v_lshlrev_b32 v20, 3, v0
    ds_read_b64 v[184:185], v20 offset:8448
    ds_read_b64 v[186:187], v20 offset:8960
    ds_read_b64 v[188:189], v20 offset:9472
    ds_read_b64 v[190:191], v20 offset:9984
    ds_read_b64 v[192:193], v20 offset:10496
    ds_read_b64 v[194:195], v20 offset:11008
    ds_read_b64 v[196:197], v20 offset:11520
    ds_read_b64 v[198:199], v20 offset:12032
    s_waitcnt lgkmcnt(0)
    v_pk_add_f32 v[184:185], v[184:185], v[186:187]
    v_pk_add_f32 v[188:189], v[188:189], v[190:191]
    v_pk_add_f32 v[192:193], v[192:193], v[194:195]
    v_pk_add_f32 v[196:197], v[196:197], v[198:199]
    v_pk_add_f32 v[184:185], v[184:185], v[188:189]
    v_pk_add_f32 v[192:193], v[192:193], v[196:197]
    v_pk_add_f32 v[184:185], v[184:185], v[192:193]
    v_mov_b32 v186, s59
    v_mov_b32 v187, s59
    global_store_dwordx4 v5, v[184:187], s[26:27] sc1
NO_QPUB:
    buffer_load_dwordx4 v[52:55], v2, s[48:51], s56 offen nt
    s_add_u32 s56, s56, 0x400
    s_and_b32 s56, s56, 0x3fff
    s_waitcnt vmcnt(5)
    buffer_load_dwordx4 v[56:59], v2, s[48:51], s56 offen nt
    s_add_u32 s56, s56, 0x400
    s_and_b32 s56, s56, 0x3fff
    s_waitcnt vmcnt(5)
    buffer_load_dwordx4 v[60:63], v2, s[48:51], s56 offen nt
    s_add_u32 s56, s56, 0x400
    s_and_b32 s56, s56, 0x3fff
    s_waitcnt vmcnt(5)
    buffer_load_dwordx4 v[64:67], v2, s[48:51], s56 offen nt
    s_add_u32 s56, s56, 0x400
    s_and_b32 s56, s56, 0x3fff
    s_waitcnt vmcnt(5)
    buffer_load_dwordx4 v[68:71], v2, s[48:51], s56 offen nt
    s_add_u32 s56, s56, 0x400
    s_and_b32 s56, s56, 0x3fff
    s_waitcnt vmcnt(5)
    buffer_load_dwordx4 v[72:75], v2, s[48:51], s56 offen nt
    s_add_u32 s56, s56, 0x400
    s_and_b32 s56, s56, 0x3fff
    s_waitcnt vmcnt(5)
    buffer_load_dwordx4 v[76:79], v2, s[48:51], s56 offen nt
    s_add_u32 s56, s56, 0x400
    s_and_b32 s56, s56, 0x3fff
    s_waitcnt vmcnt(5)
    buffer_load_dwordx4 v[80:83], v2, s[48:51], s56 offen nt
    s_add_u32 s56, s56, 0x400
    s_and_b32 s56, s56, 0x3fff
    s_waitcnt vmcnt(5)
    buffer_load_dwordx4 v[84:87], v2, s[48:51], s56 offen nt
    s_add_u32 s56, s56, 0x400
    s_and_b32 s56, s56, 0x3fff
    s_waitcnt vmcnt(5)
    buffer_load_dwordx4 v[88:91], v2, s[48:51], s56 offen nt
    s_add_u32 s56, s56, 0x400
    s_and_b32 s56, s56, 0x3fff
    s_waitcnt vmcnt(5)
    buffer_load_dwordx4 v[92:95], v2, s[48:51], s56 offen nt
    s_add_u32 s56, s56, 0x400
    s_and_b32 s56, s56, 0x3fff
    s_waitcnt vmcnt(5)
    global_load_dwordx4 v[16:19], v14, s[26:27] sc1
    s_waitcnt vmcnt(5)
    buffer_load_dwordx4 v[96:99], v4, s[52:55], s57 offen nt
    s_add_u32 s57, s57, 0x400
    s_and_b32 s57, s57, 0x3fff
    s_waitcnt vmcnt(5)
    buffer_load_dwordx4 v[100:103], v4, s[52:55], s57 offen nt
    s_add_u32 s57, s57, 0x400
    s_and_b32 s57, s57, 0x3fff
    s_waitcnt vmcnt(5)
    buffer_load_dwordx4 v[104:107], v4, s[52:55], s57 offen nt
    s_add_u32 s57, s57, 0x400
    s_and_b32 s57, s57, 0x3fff
    s_waitcnt vmcnt(5)
    buffer_load_dwordx4 v[108:111], v4, s[52:55], s57 offen nt
    s_add_u32 s57, s57, 0x400
    s_and_b32 s57, s57, 0x3fff
    s_waitcnt vmcnt(5)
    buffer_load_dwordx4 v[112:115], v4, s[52:55], s57 offen nt
    s_add_u32 s57, s57, 0x400
    s_and_b32 s57, s57, 0x3fff
    s_waitcnt vmcnt(5)
    v_cmp_ne_u32 vcc, s59, v18
    s_cbranch_vccz Q_OK
POLL_Q:
    global_load_dwordx4 v[16:19], v14, s[26:27] sc1
    s_add_u32 s41, s41, 1
    s_cmp_gt_u32 s41, 0x40000
    s_cbranch_scc1 DONE
    s_waitcnt vmcnt(0)
    v_cmp_ne_u32 vcc, s59, v18
    s_cbranch_vccnz POLL_Q
Q_OK:
    v_lshlrev_b32 v20, 3, v0
    v_lshl_add_u32 v20, v1, 9, v20
    ds_write_b64 v20, v[16:17] offset:0
    v_bfe_u32 v21, v0, 2, 2
    v_and_b32 v20, 3, v0
    v_lshl_add_u32 v20, v10, 2, v20
    v_lshlrev_b32 v20, 5, v20
    v_lshl_add_u32 v20, v21, 10, v20
    s_waitcnt lgkmcnt(0)
    s_barrier
    ds_read_b128 v[224:227], v20 offset:0
    ds_read_b128 v[228:231], v20 offset:16
    ds_read_b128 v[232:235], v20 offset:512
    ds_read_b128 v[236:239], v20 offset:528
    s_waitcnt lgkmcnt(0)
    v_pk_add_f32 v[224:225], v[224:225], v[232:233]
    v_pk_add_f32 v[226:227], v[226:227], v[234:235]
    v_pk_add_f32 v[228:229], v[228:229], v[236:237]
    v_pk_add_f32 v[230:231], v[230:231], v[238:239]
    v_add_f32_dpp v224, v224, v224 row_ror:4 row_mask:0xf bank_mask:0xf
    v_add_f32_dpp v225, v225, v225 row_ror:4 row_mask:0xf bank_mask:0xf
    v_add_f32_dpp v226, v226, v226 row_ror:4 row_mask:0xf bank_mask:0xf
    v_add_f32_dpp v227, v227, v227 row_ror:4 row_mask:0xf bank_mask:0xf
    v_add_f32_dpp v228, v228, v228 row_ror:4 row_mask:0xf bank_mask:0xf
    v_add_f32_dpp v229, v229, v229 row_ror:4 row_mask:0xf bank_mask:0xf
    v_add_f32_dpp v230, v230, v230 row_ror:4 row_mask:0xf bank_mask:0xf
    v_add_f32_dpp v231, v231, v231 row_ror:4 row_mask:0xf bank_mask:0xf
    v_add_f32_dpp v224, v224, v224 row_ror:8 row_mask:0xf bank_mask:0xf
    v_add_f32_dpp v225, v225, v225 row_ror:8 row_mask:0xf bank_mask:0xf
    v_add_f32_dpp v226, v226, v226 row_ror:8 row_mask:0xf bank_mask:0xf
    v_add_f32_dpp v227, v227, v227 row_ror:8 row_mask:0xf bank_mask:0xf
    v_add_f32_dpp v228, v228, v228 row_ror:8 row_mask:0xf bank_mask:0xf
    v_add_f32_dpp v229, v229, v229 row_ror:8 row_mask:0xf bank_mask:0xf
    v_add_f32_dpp v230, v230, v230 row_ror:8 row_mask:0xf bank_mask:0xf
    v_add_f32_dpp v231, v231, v231 row_ror:8 row_mask:0xf bank_mask:0xf
    v_cvt_pk_bf16_f32 v16, v224, v225
    v_cvt_pk_bf16_f32 v17, v226, v227
    v_cvt_pk_bf16_f32 v18, v228, v229
    v_cvt_pk_bf16_f32 v19, v230, v231
    v_cmp_eq_u32 vcc, 0, v21
    s_nop 1
    v_cndmask_b32 v224, 0, v16, vcc
    v_cndmask_b32 v225, 0, v17, vcc
    v_cndmask_b32 v226, 0, v18, vcc
    v_cndmask_b32 v227, 0, v19, vcc
    v_cmp_eq_u32 vcc, 1, v21
    s_nop 1
    v_cndmask_b32 v228, 0, v16, vcc
    v_cndmask_b32 v229, 0, v17, vcc
    v_cndmask_b32 v230, 0, v18, vcc
    v_cndmask_b32 v231, 0, v19, vcc
    v_cmp_eq_u32 vcc, 2, v21
    s_nop 1
    v_cndmask_b32 v232, 0, v16, vcc
    v_cndmask_b32 v233, 0, v17, vcc
    v_cndmask_b32 v234, 0, v18, vcc
    v_cndmask_b32 v235, 0, v19, vcc
    v_cmp_eq_u32 vcc, 3, v21
    s_nop 1
    v_cndmask_b32 v236, 0, v16, vcc
    v_cndmask_b32 v237, 0, v17, vcc
    v_cndmask_b32 v238, 0, v18, vcc
    v_cndmask_b32 v239, 0, v19, vcc
    s_nop 1
    buffer_load_dwordx4 v[116:119], v4, s[52:55], s57 offen nt
    s_add_u32 s57, s57, 0x400
    s_and_b32 s57, s57, 0x3fff
    v_mfma_f32_16x16x32_bf16 v[16:19], v[32:35], v[224:227], 0
    v_mfma_f32_16x16x32_bf16 v[16:19], v[36:39], v[228:231], v[16:19]
    v_mfma_f32_16x16x32_bf16 v[16:19], v[40:43], v[232:235], v[16:19]
    v_mfma_f32_16x16x32_bf16 v[16:19], v[44:47], v[236:239], v[16:19]
    v_mfma_f32_16x16x32_bf16 v[248:251], v[48:51], v[224:227], 0
    v_mfma_f32_16x16x32_bf16 v[248:251], v[52:55], v[228:231], v[248:251]
    v_mfma_f32_16x16x32_bf16 v[248:251], v[56:59], v[232:235], v[248:251]
    v_mfma_f32_16x16x32_bf16 v[248:251], v[60:63], v[236:239], v[248:251]
    v_mfma_f32_16x16x32_bf16 v[252:255], v[64:67], v[224:227], 0
    v_mfma_f32_16x16x32_bf16 v[252:255], v[68:71], v[228:231], v[252:255]
    v_mfma_f32_16x16x32_bf16 v[252:255], v[72:75], v[232:235], v[252:255]
    v_mfma_f32_16x16x32_bf16 v[252:255], v[76:79], v[236:239], v[252:255]
    v_mfma_f32_16x16x32_bf16 v[244:247], v[80:83], v[224:227], 0
    v_mfma_f32_16x16x32_bf16 v[244:247], v[84:87], v[228:231], v[244:247]
    v_mfma_f32_16x16x32_bf16 v[244:247], v[88:91], v[232:235], v[244:247]
    v_mfma_f32_16x16x32_bf16 v[244:247], v[92:95], v[236:239], v[244:247]
    s_waitcnt vmcnt(5)
    buffer_load_dwordx4 v[120:123], v4, s[52:55], s57 offen nt
    s_add_u32 s57, s57, 0x400
    s_and_b32 s57, s57, 0x3fff
    s_nop 7
    v_mov_b32_dpp v224, v16 quad_perm:[0,0,0,0] row_mask:0xf bank_mask:0xf
    v_mov_b32_dpp v225, v248 quad_perm:[0,0,0,0] row_mask:0xf bank_mask:0xf
    v_mov_b32_dpp v226, v252 quad_perm:[0,0,0,0] row_mask:0xf bank_mask:0xf
    v_mov_b32_dpp v227, v244 quad_perm:[0,0,0,0] row_mask:0xf bank_mask:0xf
    v_add_f32_dpp v224, v17, v224 quad_perm:[1,1,1,1] row_mask:0xf bank_mask:0xf
    v_add_f32_dpp v225, v249, v225 quad_perm:[1,1,1,1] row_mask:0xf bank_mask:0xf
    v_add_f32_dpp v226, v253, v226 quad_perm:[1,1,1,1] row_mask:0xf bank_mask:0xf
    v_add_f32_dpp v227, v245, v227 quad_perm:[1,1,1,1] row_mask:0xf bank_mask:0xf
    v_add_f32_dpp v224, v18, v224 quad_perm:[2,2,2,2] row_mask:0xf bank_mask:0xf
    v_add_f32_dpp v225, v250, v225 quad_perm:[2,2,2,2] row_mask:0xf bank_mask:0xf
    v_add_f32_dpp v226, v254, v226 quad_perm:[2,2,2,2] row_mask:0xf bank_mask:0xf
    v_add_f32_dpp v227, v246, v227 quad_perm:[2,2,2,2] row_mask:0xf bank_mask:0xf
    v_add_f32_dpp v224, v19, v224 quad_perm:[3,3,3,3] row_mask:0xf bank_mask:0xf
    v_add_f32_dpp v225, v251, v225 quad_perm:[3,3,3,3] row_mask:0xf bank_mask:0xf
    v_add_f32_dpp v226, v255, v226 quad_perm:[3,3,3,3] row_mask:0xf bank_mask:0xf
    v_add_f32_dpp v227, v247, v227 quad_perm:[3,3,3,3] row_mask:0xf bank_mask:0xf
    v_cvt_pk_bf16_f32 v224, v224, v224
    v_and_b32 v224, 0xffff0000, v224
    v_mul_f32 v224, 0x3db504f3, v224
    v_cvt_pk_bf16_f32 v224, v224, v224
    v_and_b32 v224, 0xffff0000, v224
    v_cvt_pk_bf16_f32 v225, v225, v225
    v_and_b32 v225, 0xffff0000, v225
    v_mul_f32 v225, 0x3db504f3, v225
    v_cvt_pk_bf16_f32 v225, v225, v225
    v_and_b32 v225, 0xffff0000, v225
    v_cvt_pk_bf16_f32 v226, v226, v226
    v_and_b32 v226, 0xffff0000, v226
    v_mul_f32 v226, 0x3db504f3, v226
    v_cvt_pk_bf16_f32 v226, v226, v226
    v_and_b32 v226, 0xffff0000, v226
    v_cvt_pk_bf16_f32 v227, v227, v227
    v_and_b32 v227, 0xffff0000, v227
    v_mul_f32 v227, 0x3db504f3, v227
    v_cvt_pk_bf16_f32 v227, v227, v227
    v_and_b32 v227, 0xffff0000, v227
    v_max3_f32 v16, v224, v225, v226
    v_max_f32 v16, v16, v227
    s_nop 1
    v_max_f32_dpp v16, v16, v16 row_ror:8 row_mask:0xf bank_mask:0xf
    s_nop 1
    v_max_f32_dpp v16, v16, v16 row_ror:4 row_mask:0xf bank_mask:0xf
    v_mov_b32 v18, v16
    s_nop 1
    v_permlane16_swap_b32 v18, v16
    v_max_f32 v16, v16, v18
    v_mov_b32 v18, v16
    s_nop 1
    v_permlane32_swap_b32 v18, v16
    v_max_f32 v16, v16, v18
    v_sub_f32 v224, v224, v16
    v_mul_f32 v224, 0x3fb8aa3b, v224
    v_exp_f32 v224, v224
    v_sub_f32 v225, v225, v16
    v_mul_f32 v225, 0x3fb8aa3b, v225
    v_exp_f32 v225, v225
    v_sub_f32 v226, v226, v16
    v_mul_f32 v226, 0x3fb8aa3b, v226
    v_exp_f32 v226, v226
    v_sub_f32 v227, v227, v16
    v_mul_f32 v227, 0x3fb8aa3b, v227
    v_exp_f32 v227, v227
    s_nop 0
    v_add_f32 v17, v224, v225
    v_add_f32 v18, v226, v227
    v_add_f32 v17, v17, v18
    s_nop 1
    v_add_f32_dpp v17, v17, v17 row_ror:8 row_mask:0xf bank_mask:0xf
    s_nop 1
    v_add_f32_dpp v17, v17, v17 row_ror:4 row_mask:0xf bank_mask:0xf
    v_mov_b32 v18, v17
    s_nop 1
    v_permlane16_swap_b32 v18, v17
    v_add_f32 v17, v17, v18
    v_mov_b32 v18, v17
    s_nop 1
    v_permlane32_swap_b32 v18, v17
    v_add_f32 v17, v17, v18
    s_waitcnt vmcnt(5)
    buffer_load_dwordx4 v[124:127], v4, s[52:55], s57 offen nt
    s_add_u32 s57, s57, 0x400
    s_and_b32 s57, s57, 0x3fff
    v_lshlrev_b32 v20, 3, v1
    v_and_b32 v21, 7, v0
    v_lshlrev_b32 v21, 3, v21
    s_mov_b64 exec, 1
    ds_write_b64 v20, v[16:17] offset:4096
    s_mov_b64 exec, -1
    s_waitcnt lgkmcnt(0)
    s_barrier
    ds_read_b64 v[18:19], v21 offset:4096
    s_waitcnt lgkmcnt(0)
    v_max_f32_dpp v20, v18, v18 row_half_mirror row_mask:0xf bank_mask:0xf
    s_nop 1
    v_max_f32_dpp v20, v20, v20 quad_perm:[1,0,3,2] row_mask:0xf bank_mask:0xf
    s_nop 1
    v_max_f32_dpp v20, v20, v20 quad_perm:[2,3,0,1] row_mask:0xf bank_mask:0xf
    v_sub_f32 v16, v16, v20
    v_sub_f32 v18, v18, v20
    v_mul_f32 v16, 0x3fb8aa3b, v16
    v_mul_f32 v18, 0x3fb8aa3b, v18
    v_exp_f32 v16, v16
    v_exp_f32 v18, v18
    s_nop 0
    v_mul_f32 v21, v18, v19
    v_mul_f32 v224, v224, v16
    v_cvt_pk_bf16_f32 v224, v224, v224
    v_mul_f32 v225, v225, v16
    v_cvt_pk_bf16_f32 v225, v225, v225
    v_mul_f32 v226, v226, v16
    v_cvt_pk_bf16_f32 v226, v226, v226
    v_mul_f32 v227, v227, v16
    v_cvt_pk_bf16_f32 v227, v227, v227
    v_add_f32_dpp v21, v21, v21 row_half_mirror row_mask:0xf bank_mask:0xf
    s_nop 1
    v_add_f32_dpp v21, v21, v21 quad_perm:[1,0,3,2] row_mask:0xf bank_mask:0xf
    s_nop 1
    v_add_f32_dpp v21, v21, v21 quad_perm:[2,3,0,1] row_mask:0xf bank_mask:0xf
    v_bfi_b32 v20, s58, v3, v20
    v_bfi_b32 v21, s58, v3, v21
    v_or_b32 v22, s47, v3
    v_add_u32 v5, 1048576, v24
    v_mov_b32 v23, v3
    s_cmp_lg_u32 s32, 1
    s_cbranch_scc1 NO_ML
    s_mov_b64 exec, 1
    global_store_dwordx4 v24, v[20:23], s[26:27] offset:512 sc1
    s_mov_b64 exec, -1
NO_ML:
    s_waitcnt vmcnt(5)
    buffer_load_dwordx4 v[128:131], v4, s[52:55], s57 offen nt
    s_add_u32 s57, s57, 0x400
    s_and_b32 s57, s57, 0x3fff
    v_and_b32_dpp v32, v224, v240 row_newbcast:0 row_mask:0xf bank_mask:0xf
    v_and_b32_dpp v33, v224, v241 row_newbcast:0 row_mask:0xf bank_mask:0xf
    v_and_b32_dpp v34, v224, v242 row_newbcast:0 row_mask:0xf bank_mask:0xf
    v_and_b32_dpp v35, v224, v243 row_newbcast:0 row_mask:0xf bank_mask:0xf
    v_and_b32_dpp v36, v224, v240 row_newbcast:4 row_mask:0xf bank_mask:0xf
    v_and_b32_dpp v37, v224, v241 row_newbcast:4 row_mask:0xf bank_mask:0xf
    v_and_b32_dpp v38, v224, v242 row_newbcast:4 row_mask:0xf bank_mask:0xf
    v_and_b32_dpp v39, v224, v243 row_newbcast:4 row_mask:0xf bank_mask:0xf
    v_and_b32_dpp v40, v224, v240 row_newbcast:8 row_mask:0xf bank_mask:0xf
    v_and_b32_dpp v41, v224, v241 row_newbcast:8 row_mask:0xf bank_mask:0xf
    v_and_b32_dpp v42, v224, v242 row_newbcast:8 row_mask:0xf bank_mask:0xf
    v_and_b32_dpp v43, v224, v243 row_newbcast:8 row_mask:0xf bank_mask:0xf
    v_and_b32_dpp v44, v224, v240 row_newbcast:12 row_mask:0xf bank_mask:0xf
    v_and_b32_dpp v45, v224, v241 row_newbcast:12 row_mask:0xf bank_mask:0xf
    v_and_b32_dpp v46, v224, v242 row_newbcast:12 row_mask:0xf bank_mask:0xf
    v_and_b32_dpp v47, v224, v243 row_newbcast:12 row_mask:0xf bank_mask:0xf
    v_and_b32_dpp v48, v225, v240 row_newbcast:0 row_mask:0xf bank_mask:0xf
    v_and_b32_dpp v49, v225, v241 row_newbcast:0 row_mask:0xf bank_mask:0xf
    v_and_b32_dpp v50, v225, v242 row_newbcast:0 row_mask:0xf bank_mask:0xf
    v_and_b32_dpp v51, v225, v243 row_newbcast:0 row_mask:0xf bank_mask:0xf
    v_and_b32_dpp v52, v225, v240 row_newbcast:4 row_mask:0xf bank_mask:0xf
    v_and_b32_dpp v53, v225, v241 row_newbcast:4 row_mask:0xf bank_mask:0xf
    v_and_b32_dpp v54, v225, v242 row_newbcast:4 row_mask:0xf bank_mask:0xf
    v_and_b32_dpp v55, v225, v243 row_newbcast:4 row_mask:0xf bank_mask:0xf
    v_and_b32_dpp v56, v225, v240 row_newbcast:8 row_mask:0xf bank_mask:0xf
    v_and_b32_dpp v57, v225, v241 row_newbcast:8 row_mask:0xf bank_mask:0xf
    v_and_b32_dpp v58, v225, v242 row_newbcast:8 row_mask:0xf bank_mask:0xf
    v_and_b32_dpp v59, v225, v243 row_newbcast:8 row_mask:0xf bank_mask:0xf
    v_and_b32_dpp v60, v225, v240 row_newbcast:12 row_mask:0xf bank_mask:0xf
    v_and_b32_dpp v61, v225, v241 row_newbcast:12 row_mask:0xf bank_mask:0xf
    v_and_b32_dpp v62, v225, v242 row_newbcast:12 row_mask:0xf bank_mask:0xf
    v_and_b32_dpp v63, v225, v243 row_newbcast:12 row_mask:0xf bank_mask:0xf
    v_and_b32_dpp v64, v226, v240 row_newbcast:0 row_mask:0xf bank_mask:0xf
    v_and_b32_dpp v65, v226, v241 row_newbcast:0 row_mask:0xf bank_mask:0xf
    v_and_b32_dpp v66, v226, v242 row_newbcast:0 row_mask:0xf bank_mask:0xf
    v_and_b32_dpp v67, v226, v243 row_newbcast:0 row_mask:0xf bank_mask:0xf
    v_and_b32_dpp v68, v226, v240 row_newbcast:4 row_mask:0xf bank_mask:0xf
    v_and_b32_dpp v69, v226, v241 row_newbcast:4 row_mask:0xf bank_mask:0xf
    v_and_b32_dpp v70, v226, v242 row_newbcast:4 row_mask:0xf bank_mask:0xf
    v_and_b32_dpp v71, v226, v243 row_newbcast:4 row_mask:0xf bank_mask:0xf
    v_and_b32_dpp v72, v226, v240 row_newbcast:8 row_mask:0xf bank_mask:0xf
    v_and_b32_dpp v73, v226, v241 row_newbcast:8 row_mask:0xf bank_mask:0xf
    v_and_b32_dpp v74, v226, v242 row_newbcast:8 row_mask:0xf bank_mask:0xf
    v_and_b32_dpp v75, v226, v243 row_newbcast:8 row_mask:0xf bank_mask:0xf
    v_and_b32_dpp v76, v226, v240 row_newbcast:12 row_mask:0xf bank_mask:0xf
    v_and_b32_dpp v77, v226, v241 row_newbcast:12 row_mask:0xf bank_mask:0xf
    v_and_b32_dpp v78, v226, v242 row_newbcast:12 row_mask:0xf bank_mask:0xf
    v_and_b32_dpp v79, v226, v243 row_newbcast:12 row_mask:0xf bank_mask:0xf
    v_and_b32_dpp v80, v227, v240 row_newbcast:0 row_mask:0xf bank_mask:0xf
    v_and_b32_dpp v81, v227, v241 row_newbcast:0 row_mask:0xf bank_mask:0xf
    v_and_b32_dpp v82, v227, v242 row_newbcast:0 row_mask:0xf bank_mask:0xf
    v_and_b32_dpp v83, v227, v243 row_newbcast:0 row_mask:0xf bank_mask:0xf
    v_and_b32_dpp v84, v227, v240 row_newbcast:4 row_mask:0xf bank_mask:0xf
    v_and_b32_dpp v85, v227, v241 row_newbcast:4 row_mask:0xf bank_mask:0xf
    v_and_b32_dpp v86, v227, v242 row_newbcast:4 row_mask:0xf bank_mask:0xf
    v_and_b32_dpp v87, v227, v243 row_newbcast:4 row_mask:0xf bank_mask:0xf
    v_and_b32_dpp v88, v227, v240 row_newbcast:8 row_mask:0xf bank_mask:0xf
    v_and_b32_dpp v89, v227, v241 row_newbcast:8 row_mask:0xf bank_mask:0xf
    v_and_b32_dpp v90, v227, v242 row_newbcast:8 row_mask:0xf bank_mask:0xf
    v_and_b32_dpp v91, v227, v243 row_newbcast:8 row_mask:0xf bank_mask:0xf
    v_and_b32_dpp v92, v227, v240 row_newbcast:12 row_mask:0xf bank_mask:0xf
    v_and_b32_dpp v93, v227, v241 row_newbcast:12 row_mask:0xf bank_mask:0xf
    v_and_b32_dpp v94, v227, v242 row_newbcast:12 row_mask:0xf bank_mask:0xf
    v_and_b32_dpp v95, v227, v243 row_newbcast:12 row_mask:0xf bank_mask:0xf
    s_nop 0
    s_waitcnt vmcnt(5)
    buffer_load_dwordx4 v[132:135], v4, s[52:55], s57 offen nt
    s_add_u32 s57, s57, 0x400
    s_and_b32 s57, s57, 0x3fff
    v_mfma_f32_16x16x32_bf16 v[244:247], v[32:35], v[96:99], 0
    v_mfma_f32_16x16x32_bf16 v[244:247], v[36:39], v[100:103], v[244:247]
    v_mfma_f32_16x16x32_bf16 v[244:247], v[40:43], v[104:107], v[244:247]
    v_mfma_f32_16x16x32_bf16 v[244:247], v[44:47], v[108:111], v[244:247]
    s_waitcnt vmcnt(5)
    buffer_load_dwordx4 v[136:139], v4, s[52:55], s57 offen nt
    s_add_u32 s57, s57, 0x400
    s_and_b32 s57, s57, 0x3fff
    v_mfma_f32_16x16x32_bf16 v[244:247], v[48:51], v[112:115], v[244:247]
    s_waitcnt vmcnt(5)
    buffer_load_dwordx4 v[140:143], v4, s[52:55], s57 offen nt
    s_add_u32 s57, s57, 0x400
    s_and_b32 s57, s57, 0x3fff
    v_mfma_f32_16x16x32_bf16 v[244:247], v[52:55], v[116:119], v[244:247]
    s_waitcnt vmcnt(5)
    buffer_load_dwordx4 v[144:147], v4, s[52:55], s57 offen nt
    s_add_u32 s57, s57, 0x400
    s_and_b32 s57, s57, 0x3fff
    v_mfma_f32_16x16x32_bf16 v[244:247], v[56:59], v[120:123], v[244:247]
    s_waitcnt vmcnt(5)
    buffer_load_dwordx4 v[148:151], v4, s[52:55], s57 offen nt
    s_add_u32 s57, s57, 0x400
    s_and_b32 s57, s57, 0x3fff
    v_mfma_f32_16x16x32_bf16 v[244:247], v[60:63], v[124:127], v[244:247]
    s_waitcnt vmcnt(5)
    buffer_load_dwordx4 v[152:155], v4, s[52:55], s57 offen nt
    s_add_u32 s57, s57, 0x400
    s_and_b32 s57, s57, 0x3fff
    v_mfma_f32_16x16x32_bf16 v[244:247], v[64:67], v[128:131], v[244:247]
    s_waitcnt vmcnt(5)
    buffer_load_dwordx4 v[156:159], v4, s[52:55], s57 offen nt
    s_add_u32 s57, s57, 0x400
    s_and_b32 s57, s57, 0x3fff
    v_mfma_f32_16x16x32_bf16 v[244:247], v[68:71], v[132:135], v[244:247]
    global_load_dword v221, v218, s[12:13]
    global_load_dwordx4 v[208:211], v30, s[26:27] offset:512 sc1
    s_cmp_eq_u32 s34, 1
    s_cbranch_scc1 PV_W
    s_waitcnt vmcnt(7)
    v_mfma_f32_16x16x32_bf16 v[244:247], v[72:75], v[136:139], v[244:247]
    s_waitcnt vmcnt(6)
    v_mfma_f32_16x16x32_bf16 v[244:247], v[76:79], v[140:143], v[244:247]
    s_waitcnt vmcnt(5)
    v_mfma_f32_16x16x32_bf16 v[244:247], v[80:83], v[144:147], v[244:247]
    s_waitcnt vmcnt(4)
    v_mfma_f32_16x16x32_bf16 v[244:247], v[84:87], v[148:151], v[244:247]
    global_load_dword v221, v219, s[16:17]
    global_load_dword v221, v219, s[18:19]
    s_waitcnt vmcnt(5)
    v_mfma_f32_16x16x32_bf16 v[244:247], v[88:91], v[152:155], v[244:247]
    s_waitcnt vmcnt(4)
    v_mfma_f32_16x16x32_bf16 v[244:247], v[92:95], v[156:159], v[244:247]
    global_load_dword v221, v220, s[20:21]
    s_branch PV_DONE
PV_W:
    s_waitcnt vmcnt(7)
    v_mfma_f32_16x16x32_bf16 v[244:247], v[72:75], v[136:139], v[244:247]
    s_waitcnt vmcnt(6)
    v_mfma_f32_16x16x32_bf16 v[244:247], v[76:79], v[140:143], v[244:247]
    s_waitcnt vmcnt(5)
    v_mfma_f32_16x16x32_bf16 v[244:247], v[80:83], v[144:147], v[244:247]
    s_waitcnt vmcnt(4)
    v_mfma_f32_16x16x32_bf16 v[244:247], v[84:87], v[148:151], v[244:247]
    s_waitcnt vmcnt(3)
    v_mfma_f32_16x16x32_bf16 v[244:247], v[88:91], v[152:155], v[244:247]
    s_waitcnt vmcnt(2)
    v_mfma_f32_16x16x32_bf16 v[244:247], v[92:95], v[156:159], v[244:247]
    global_load_dwordx4 v[160:163], v[6:7], off nt
    v_lshl_add_u64 v[6:7], v[6:7], 0, s[44:45]
    global_load_dwordx4 v[164:167], v[6:7], off nt
    v_lshl_add_u64 v[6:7], v[6:7], 0, s[44:45]
    global_load_dwordx4 v[168:171], v[6:7], off nt
    v_lshl_add_u64 v[6:7], v[6:7], 0, s[44:45]
    global_load_dwordx4 v[172:175], v[6:7], off nt
    v_lshl_add_u64 v[6:7], v[6:7], 0, s[44:45]
PV_DONE:
    s_nop 6
    s_mov_b32 exec_hi, 0
    ds_write_b128 v26, v[244:247] offset:4352
    s_waitcnt lgkmcnt(0)
    s_barrier
    s_cmp_lg_u32 s32, 0
    s_cbranch_scc1 NO_PUB
    ds_read_b128 v[32:35], v12 offset:4352
    ds_read_b128 v[36:39], v12 offset:4864
    ds_read_b128 v[40:43], v12 offset:5376
    ds_read_b128 v[44:47], v12 offset:5888
    ds_read_b128 v[48:51], v12 offset:6400
    ds_read_b128 v[52:55], v12 offset:6912
    ds_read_b128 v[56:59], v12 offset:7424
    ds_read_b128 v[60:63], v12 offset:7936
    s_waitcnt lgkmcnt(6)
    v_pk_add_f32 v[32:33], v[32:33], v[36:37]
    v_pk_add_f32 v[34:35], v[34:35], v[38:39]
    s_waitcnt lgkmcnt(4)
    v_pk_add_f32 v[40:41], v[40:41], v[44:45]
    v_pk_add_f32 v[42:43], v[42:43], v[46:47]
    s_waitcnt lgkmcnt(2)
    v_pk_add_f32 v[48:49], v[48:49], v[52:53]
    v_pk_add_f32 v[50:51], v[50:51], v[54:55]
    s_waitcnt lgkmcnt(0)
    v_pk_add_f32 v[56:57], v[56:57], v[60:61]
    v_pk_add_f32 v[58:59], v[58:59], v[62:63]
    v_pk_add_f32 v[32:33], v[32:33], v[40:41]
    v_pk_add_f32 v[34:35], v[34:35], v[42:43]
    v_pk_add_f32 v[48:49], v[48:49], v[56:57]
    v_pk_add_f32 v[50:51], v[50:51], v[58:59]
    v_pk_add_f32 v[32:33], v[32:33], v[48:49]
    v_pk_add_f32 v[34:35], v[34:35], v[50:51]
    v_bfi_b32 v32, s58, v3, v32
    v_bfi_b32 v33, s58, v3, v33
    v_bfi_b32 v34, s58, v3, v34
    v_bfi_b32 v35, s58, v3, v35
    global_store_dwordx4 v5, v[32:35], s[26:27]
    global_store_dwordx4 v24, v[32:35], s[26:27] sc1
NO_PUB:
    s_mov_b32 exec_hi, -1
    s_cmp_eq_u32 s34, 0
    s_cbranch_scc1 DONE
    s_lshr_b32 s33, 2, s34
    s_bitcmp1_b32 s33, 0
    s_cbranch_scc1 W_ISSUED
    s_cmp_eq_u32 s34, 3
    s_cbranch_scc1 W_D
    s_cmp_eq_u32 s32, 0
    s_cbranch_scc1 W_0
    s_waitcnt vmcnt(1)
W_0:
    s_waitcnt vmcnt(3)
    s_branch W_GO
W_D:
    s_waitcnt vmcnt(0)
W_GO:
    global_load_dwordx4 v[160:163], v[6:7], off nt
    v_lshl_add_u64 v[6:7], v[6:7], 0, s[44:45]
    global_load_dwordx4 v[164:167], v[6:7], off nt
    v_lshl_add_u64 v[6:7], v[6:7], 0, s[44:45]
    global_load_dwordx4 v[168:171], v[6:7], off nt
    v_lshl_add_u64 v[6:7], v[6:7], 0, s[44:45]
    global_load_dwordx4 v[172:175], v[6:7], off nt
    v_lshl_add_u64 v[6:7], v[6:7], 0, s[44:45]
W_ISSUED:
    s_cmp_eq_u32 s34, 3
    s_cbranch_scc1 ROLE_D
    s_cmp_eq_u32 s34, 2
    s_cbranch_scc1 ROLE_C
    s_mov_b64 exec, 0
    s_branch TWB0
TWBR:
    s_mov_b64 exec, -1
    s_cmp_eq_u32 s32, 0
    s_cbranch_scc1 B_W0
    s_waitcnt vmcnt(0)
B_W0:
    s_waitcnt vmcnt(2)
    ds_write_b128 v217, v[160:163] offset:0
    ds_write_b128 v217, v[164:167] offset:1024
    ds_write_b128 v217, v[168:171] offset:2048
    ds_write_b128 v217, v[172:175] offset:3072
    v_xor_b32 v208, v3, v208
    v_xor_b32 v209, v3, v209
    v_xor_b32 v210, v3, v210
    v_xor_b32 v211, v3, v211
    v_or3_b32 v20, v208, v209, v210
    v_bitop3_b32 v20, v20, v211, s58 bitop3:0xa8
    v_cmp_ne_u32 vcc, 0, v20
    s_cbranch_vccz ML_OK
POLL_ML:
    global_load_dwordx4 v[208:211], v30, s[26:27] offset:512 sc1
    s_add_u32 s41, s41, 1
    s_cmp_gt_u32 s41, 0x40000
    s_cbranch_scc1 DONE
    s_waitcnt vmcnt(0)
    v_xor_b32 v208, v3, v208
    v_xor_b32 v209, v3, v209
    v_xor_b32 v210, v3, v210
    v_xor_b32 v211, v3, v211
    v_or3_b32 v20, v208, v209, v210
    v_bitop3_b32 v20, v20, v211, s58 bitop3:0xa8
    v_cmp_ne_u32 vcc, 0, v20
    s_cbranch_vccnz POLL_ML
ML_OK:
    v_cmp_ne_u32 vcc, s47, v210
    s_cbranch_vccnz A_FAR
    v_add_u32 v29, 1048576, v29
A_FAR:
    global_load_dword v96, v29, s[26:27] offset:-2560 sc1
    global_load_dword v97, v29, s[26:27] offset:-1920 sc1
    global_load_dword v98, v29, s[26:27] offset:-1280 sc1
    global_load_dword v99, v29, s[26:27] offset:-640 sc1
    global_load_dword v100, v29, s[26:27] offset:0 sc1
    global_load_dword v101, v29, s[26:27] offset:640 sc1
    global_load_dword v102, v29, s[26:27] offset:1280 sc1
    global_load_dword v103, v29, s[26:27] offset:1920 sc1
    s_waitcnt lgkmcnt(0)
    ds_read_b64_tr_b16 v[184:185], v216 offset:0
    ds_read_b64_tr_b16 v[186:187], v216 offset:256
    ds_read_b64_tr_b16 v[188:189], v216 offset:2048
    ds_read_b64_tr_b16 v[190:191], v216 offset:2304
    ds_read_b64_tr_b16 v[192:193], v216 offset:32
    ds_read_b64_tr_b16 v[194:195], v216 offset:288
    ds_read_b64_tr_b16 v[196:197], v216 offset:2080
    ds_read_b64_tr_b16 v[198:199], v216 offset:2336
    v_max_f32_dpp v20, v208, v208 row_half_mirror row_mask:0xf bank_mask:0xf
    s_nop 1
    v_max_f32_dpp v20, v20, v20 quad_perm:[1,0,3,2] row_mask:0xf bank_mask:0xf
    s_nop 1
    v_max_f32_dpp v20, v20, v20 quad_perm:[2,3,0,1] row_mask:0xf bank_mask:0xf
    v_sub_f32 v18, v208, v20
    v_mul_f32 v18, 0x3fb8aa3b, v18
    v_exp_f32 v18, v18
    s_nop 0
    v_mul_f32 v21, v18, v209
    s_nop 1
    v_add_f32_dpp v21, v21, v21 row_half_mirror row_mask:0xf bank_mask:0xf
    s_nop 1
    v_add_f32_dpp v21, v21, v21 quad_perm:[1,0,3,2] row_mask:0xf bank_mask:0xf
    s_nop 1
    v_add_f32_dpp v21, v21, v21 quad_perm:[2,3,0,1] row_mask:0xf bank_mask:0xf
    v_rcp_f32 v21, v21
    s_nop 0
    v_mul_f32 v18, v18, v21
    s_nop 1
    v_mov_b32_dpp v40, v18 row_newbcast:0 row_mask:0xf bank_mask:0xf
    v_mov_b32_dpp v41, v18 row_newbcast:1 row_mask:0xf bank_mask:0xf
    v_mov_b32_dpp v42, v18 row_newbcast:2 row_mask:0xf bank_mask:0xf
    v_mov_b32_dpp v43, v18 row_newbcast:3 row_mask:0xf bank_mask:0xf
    v_mov_b32_dpp v44, v18 row_newbcast:4 row_mask:0xf bank_mask:0xf
    v_mov_b32_dpp v45, v18 row_newbcast:5 row_mask:0xf bank_mask:0xf
    v_mov_b32_dpp v46, v18 row_newbcast:6 row_mask:0xf bank_mask:0xf
    v_mov_b32_dpp v47, v18 row_newbcast:7 row_mask:0xf bank_mask:0xf
    s_branch POLL_A_W
POLL_A:
    global_load_dword v96, v29, s[26:27] offset:-2560 sc1
    global_load_dword v97, v29, s[26:27] offset:-1920 sc1
    global_load_dword v98, v29, s[26:27] offset:-1280 sc1
    global_load_dword v99, v29, s[26:27] offset:-640 sc1
    global_load_dword v100, v29, s[26:27] offset:0 sc1
    global_load_dword v101, v29, s[26:27] offset:640 sc1
    global_load_dword v102, v29, s[26:27] offset:1280 sc1
    global_load_dword v103, v29, s[26:27] offset:1920 sc1
POLL_A_W:
    s_add_u32 s41, s41, 1
    s_cmp_gt_u32 s41, 0x40000
    s_cbranch_scc1 DONE
    s_waitcnt vmcnt(0)
    v_xor_b32 v96, v3, v96
    v_xor_b32 v97, v3, v97
    v_xor_b32 v98, v3, v98
    v_xor_b32 v99, v3, v99
    v_xor_b32 v100, v3, v100
    v_xor_b32 v101, v3, v101
    v_xor_b32 v102, v3, v102
    v_xor_b32 v103, v3, v103
    v_or3_b32 v20, v96, v97, v98
    v_or3_b32 v21, v99, v100, v101
    v_or3_b32 v20, v20, v102, v103
    v_bitop3_b32 v20, v20, v21, s58 bitop3:0xa8
    v_cmp_ne_u32 vcc, 0, v20
    s_cbranch_vccnz POLL_A
    v_pk_mul_f32 v[16:17], v[40:41], v[96:97]
    v_pk_mul_f32 v[18:19], v[42:43], v[98:99]
    v_pk_fma_f32 v[16:17], v[44:45], v[100:101], v[16:17]
    v_pk_fma_f32 v[18:19], v[46:47], v[102:103], v[18:19]
    v_pk_add_f32 v[16:17], v[16:17], v[18:19]
    v_add_f32 v16, v16, v17
    v_cvt_pk_bf16_f32 v16, v16, v16
    ds_write_b16 v8, v16
    s_waitcnt lgkmcnt(0)
    ds_read_b128 v[224:227], v9
    ds_read_b128 v[228:231], v9 offset:64
    s_waitcnt lgkmcnt(1)
    v_mfma_f32_16x16x32_bf16 v[244:247], v[224:227], v[184:187], 0
    v_mfma_f32_16x16x32_bf16 v[248:251], v[224:227], v[192:195], 0
TWB0:
    s_cbranch_execz TWB1
    s_waitcnt lgkmcnt(0)
    v_mfma_f32_16x16x32_bf16 v[244:247], v[228:231], v[188:191], v[244:247]
    v_mfma_f32_16x16x32_bf16 v[248:251], v[228:231], v[196:199], v[248:251]
    s_mov_b64 exec, 0xffff
    s_nop 6
    ds_write2_b32 v27, v244, v248 offset1:128
    s_mov_b64 exec, -1
    s_waitcnt lgkmcnt(0)
    s_barrier
    s_cmp_lg_u32 s32, 0
    s_cbranch_scc1 DONE
    ds_read_b128 v[32:35], v28 offset:15616
    ds_read_b128 v[36:39], v28 offset:15632
    s_waitcnt lgkmcnt(0)
    v_pk_add_f32 v[32:33], v[32:33], v[36:37]
    v_pk_add_f32 v[34:35], v[34:35], v[38:39]
    v_pk_add_f32 v[32:33], v[32:33], v[34:35]
    v_add_f32 v16, v32, v33
    v_bfi_b32 v16, s58, v3, v16
    global_store_dword v31, v16, s[26:27] offset:-4096 sc1
    global_store_dword v31, v16, s[26:27] offset:-2048 sc1
    global_store_dword v31, v16, s[26:27] offset:0 sc1
    global_store_dword v31, v16, s[26:27] offset:2048 sc1
    s_branch DONE
TWB1:
    s_branch TWBR
ROLE_C:
    v_lshl_add_u32 v21, v1, 6, v0
    v_lshlrev_b32 v21, 1, v21
    global_load_short_d16_hi v15, v21, s[4:5]
    v_mov_b32 v212, 0x3f803f80
    v_mov_b32 v213, 0x3f803f80
    v_mov_b32 v214, 0x3f803f80
    v_mov_b32 v215, 0x3f803f80
    v_mov_b32 v13, 0
    v_add_u32 v14, 1152, v27
    s_and_b32 s43, s59, 0xffff
    v_add_u32 v145, 65536, v31
    s_mov_b64 exec, 0
    s_branch TWC0
TWCR:
    s_mov_b64 exec, -1
    s_waitcnt vmcnt(0)
    v_and_b32 v15, 0xffff0000, v15
    ds_write_b128 v217, v[160:163] offset:0
    ds_write_b128 v217, v[164:167] offset:1024
    ds_write_b128 v217, v[168:171] offset:2048
    ds_write_b128 v217, v[172:175] offset:3072
    s_waitcnt lgkmcnt(0)
    ds_read_b64_tr_b16 v[184:185], v216 offset:0
    ds_read_b64_tr_b16 v[186:187], v216 offset:256
    ds_read_b64_tr_b16 v[188:189], v216 offset:2048
    ds_read_b64_tr_b16 v[190:191], v216 offset:2304
    ds_read_b64_tr_b16 v[192:193], v216 offset:32
    ds_read_b64_tr_b16 v[194:195], v216 offset:288
    ds_read_b64_tr_b16 v[196:197], v216 offset:2080
    ds_read_b64_tr_b16 v[198:199], v216 offset:2336
    s_waitcnt lgkmcnt(0)
    v_mfma_f32_16x16x32_bf16 v[244:247], v[212:215], v[184:187], 0
    v_mfma_f32_16x16x32_bf16 v[248:251], v[212:215], v[192:195], 0
    v_mfma_f32_16x16x32_bf16 v[244:247], v[212:215], v[188:191], v[244:247]
    v_mfma_f32_16x16x32_bf16 v[248:251], v[212:215], v[196:199], v[248:251]
    s_mov_b64 exec, 0xffff
    s_nop 6
    ds_write2_b32 v14, v244, v248 offset1:128
    s_mov_b64 exec, -1
    s_cmp_lg_u32 s32, 0
    s_cbranch_scc1 PRE_OK
    s_and_b32 s33, s35, 15
    s_lshl_b32 s33, s33, 3
    s_and_b32 s42, s28, 7
    s_add_u32 s33, s33, s42
    s_lshl_b32 s33, s33, 10
    s_add_u32 s33, s33, 1310720
    v_lshl_add_u32 v21, v0, 7, s33
    s_mov_b64 exec, 0xff
PRE:
    global_load_dword v22, v21, s[26:27] sc1
    s_add_u32 s41, s41, 1
    s_cmp_gt_u32 s41, 0x40000
    s_cbranch_scc1 DONE
    s_waitcnt vmcnt(0)
    v_and_b32 v22, 0xff, v22
    v_cmp_eq_u32 vcc, v22, v3
    s_bcnt1_i32_b64 s33, vcc
    s_cmp_lt_u32 s33, 4
    s_cbranch_scc1 PRE
    s_mov_b64 exec, -1
PRE_OK:
    s_waitcnt lgkmcnt(0)
    s_barrier
    ds_read_b128 v[32:35], v28 offset:16768
    ds_read_b128 v[36:39], v28 offset:16784
    s_waitcnt lgkmcnt(0)
    v_pk_add_f32 v[32:33], v[32:33], v[36:37]
    v_pk_add_f32 v[34:35], v[34:35], v[38:39]
    v_pk_add_f32 v[32:33], v[32:33], v[34:35]
    v_add_f32 v14, v32, v33
POLL_B:
    global_load_dword v96, v29, s[26:27] offset:0 sc1
    global_load_dword v97, v29, s[26:27] offset:128 sc1
    global_load_dword v98, v29, s[26:27] offset:256 sc1
    global_load_dword v99, v29, s[26:27] offset:384 sc1
    global_load_dword v100, v29, s[26:27] offset:512 sc1
    global_load_dword v101, v29, s[26:27] offset:640 sc1
    global_load_dword v102, v29, s[26:27] offset:768 sc1
    global_load_dword v103, v29, s[26:27] offset:896 sc1
    s_add_u32 s41, s41, 1
    s_cmp_gt_u32 s41, 0x40000
    s_cbranch_scc1 DONE
    s_waitcnt vmcnt(0)
    v_xor_b32 v96, v3, v96
    v_xor_b32 v97, v3, v97
    v_xor_b32 v98, v3, v98
    v_xor_b32 v99, v3, v99
    v_xor_b32 v100, v3, v100
    v_xor_b32 v101, v3, v101
    v_xor_b32 v102, v3, v102
    v_xor_b32 v103, v3, v103
    v_or3_b32 v22, v96, v97, v98
    v_or3_b32 v23, v99, v100, v101
    v_or3_b32 v22, v22, v102, v103
    v_bitop3_b32 v22, v22, v23, s58 bitop3:0xa8
    v_cmp_ne_u32 vcc, 0, v22
    s_cbranch_vccnz POLL_B
    v_pk_add_f32 v[96:97], v[96:97], v[98:99]
    v_pk_add_f32 v[100:101], v[100:101], v[102:103]
    v_pk_add_f32 v[96:97], v[96:97], v[100:101]
    v_add_f32 v16, v96, v97
    v_cvt_pk_bf16_f32 v16, v16, v16
    v_and_b32 v16, 0xffff0000, v16
    v_add_f32 v16, v15, v16
    v_cvt_pk_bf16_f32 v16, v16, v16
    ds_write_b16 v8, v16
    s_waitcnt lgkmcnt(0)
    ds_read_b128 v[224:227], v9
    ds_read_b128 v[228:231], v9 offset:64
    s_waitcnt lgkmcnt(1)
    v_mfma_f32_16x16x32_bf16 v[244:247], v[224:227], v[184:187], 0
TWC0:
    s_cbranch_execz TWC1
    v_mfma_f32_16x16x32_bf16 v[248:251], v[224:227], v[192:195], 0
    v_mfma_f32_16x16x32_bf16 v[32:35], v[224:227], v[212:215], 0
    v_mfma_f32_16x16x32_bf16 v[36:39], v[224:227], v[224:227], 0
    s_waitcnt lgkmcnt(0)
    v_mfma_f32_16x16x32_bf16 v[244:247], v[228:231], v[188:191], v[244:247]
    v_mfma_f32_16x16x32_bf16 v[248:251], v[228:231], v[196:199], v[248:251]
    v_mfma_f32_16x16x32_bf16 v[32:35], v[228:231], v[212:215], v[32:35]
    v_mfma_f32_16x16x32_bf16 v[36:39], v[228:231], v[228:231], v[36:39]
    s_mov_b64 exec, 0xffff
    s_nop 4
    ds_write2_b32 v27, v244, v248 offset1:128
    s_mov_b64 exec, 1
    ds_write_b32 v27, v32 offset:1024
    ds_write_b32 v27, v36 offset:1056
    s_mov_b64 exec, -1
    s_waitcnt lgkmcnt(0)
    s_barrier
    s_cmp_lg_u32 s32, 0
    s_cbranch_scc1 DONE
    ds_read_b128 v[32:35], v28 offset:15616
    ds_read_b128 v[36:39], v28 offset:15632
    ds_read_b128 v[40:43], v13 offset:16640
    ds_read_b128 v[44:47], v13 offset:16656
    ds_read_b128 v[48:51], v13 offset:16672
    ds_read_b128 v[52:55], v13 offset:16688
    s_waitcnt lgkmcnt(4)
    v_pk_add_f32 v[32:33], v[32:33], v[36:37]
    v_pk_add_f32 v[34:35], v[34:35], v[38:39]
    s_waitcnt lgkmcnt(2)
    v_pk_add_f32 v[40:41], v[40:41], v[44:45]
TWC1:
    s_cbranch_execz TWC2
    v_pk_add_f32 v[42:43], v[42:43], v[46:47]
    s_waitcnt lgkmcnt(0)
    v_pk_add_f32 v[48:49], v[48:49], v[52:53]
    v_pk_add_f32 v[50:51], v[50:51], v[54:55]
    v_pk_add_f32 v[32:33], v[32:33], v[34:35]
    v_pk_add_f32 v[40:41], v[40:41], v[42:43]
    v_pk_add_f32 v[48:49], v[48:49], v[50:51]
    v_add_f32 v16, v32, v33
    v_add_f32 v17, v40, v41
    v_add_f32 v18, v48, v49
    v_mul_f32 v17, 0x3b000000, v17
    v_mul_f32 v18, 0x3b000000, v18
    v_fma_f32 v18, -v17, v17, v18
    v_max_f32 v18, 0, v18
    v_cvt_pk_bf16_f32 v18, v17, v18
    v_lshlrev_b32 v17, 16, v18
    v_and_b32 v18, 0xffff0000, v18
    v_add_f32 v18, 0x3727c5ac, v18
    v_cvt_pk_bf16_f32 v18, v18, v18
    v_and_b32 v18, 0xffff0000, v18
    v_sqrt_f32 v18, v18
    v_fma_f32 v16, -v17, v14, v16
    v_cvt_pk_bf16_f32 v18, v18, v18
    v_and_b32 v18, 0xffff0000, v18
    v_rcp_f32 v18, v18
    s_nop 0
    v_mul_f32 v16, v16, v18
    v_cvt_pk_bf16_f32 v16, v16, v16
    v_and_b32 v16, 0xffff0000, v16
    v_mov_b32 v17, v16
TWC2:
    s_cbranch_execz TWC3
    s_nop 1
    v_permlane16_swap_b32 v16, v17
    v_max_f32 v16, 0, v16
    v_mul_f32 v16, v16, v17
    v_cvt_pk_bf16_f32 v16, v16, v16
    v_lshl_or_b32 v16, v16, 16, s43
    global_store_dword v31, v16, s[26:27] sc1
    global_store_dword v145, v16, s[26:27] sc1
    s_branch DONE
TWC3:
    s_branch TWCR
ROLE_D:
    global_load_dwordx4 v[176:179], v[6:7], off nt
    v_lshl_add_u64 v[6:7], v[6:7], 0, s[44:45]
    s_cmp_ge_u32 s32, 3
    s_cbranch_scc1 D_5
    global_load_dwordx4 v[180:183], v[6:7], off nt
    v_lshl_add_u64 v[6:7], v[6:7], 0, s[44:45]
D_5:
    global_load_short_d16_hi v15, v31, s[4:5]
    v_lshrrev_b32 v13, 3, v0
    v_lshl_add_u32 v13, v13, 3, v1
    v_lshlrev_b32 v13, 8, v13
    v_and_b32 v14, 0x70, v12
    v_and_b32 v20, 0x40, v12
    v_add_u32 v14, v14, v20
    s_lshr_b32 s43, s35, 2
    s_lshl_b32 s43, s43, 14
    s_add_u32 s43, s43, 1572864
    v_add3_u32 v13, v13, v14, s43
    s_mul_i32 s33, s32, 384
    s_add_u32 s33, s33, 12544
    v_lshl_add_u32 v8, v0, 3, s33
    s_and_b32 s33, s59, 0xffff
    v_mov_b32 v14, s33
    s_mov_b32 s46, 0xffff
    s_mov_b32 s42, 0x07060302
    s_cmp_lt_u32 s32, 3
    s_cselect_b32 s47, s46, s58
    s_mov_b64 exec, 0
    s_branch TWD0
TWDR:
    s_mov_b64 exec, -1
    s_waitcnt vmcnt(0)
    v_and_b32 v15, 0xffff0000, v15
    ds_write_b128 v217, v[160:163] offset:0
    ds_write_b128 v217, v[164:167] offset:1024
    ds_write_b128 v217, v[168:171] offset:2048
    ds_write_b128 v217, v[172:175] offset:3072
    ds_write_b128 v217, v[176:179] offset:4096
    ds_write_b128 v217, v[180:183] offset:5120
    s_waitcnt lgkmcnt(0)
    ds_read_b64_tr_b16 v[184:185], v216 offset:0
    ds_read_b64_tr_b16 v[186:187], v216 offset:128
    ds_read_b64_tr_b16 v[188:189], v216 offset:1024
    ds_read_b64_tr_b16 v[190:191], v216 offset:1152
    ds_read_b64_tr_b16 v[192:193], v216 offset:2048
    ds_read_b64_tr_b16 v[194:195], v216 offset:2176
    ds_read_b64_tr_b16 v[196:197], v216 offset:3072
    ds_read_b64_tr_b16 v[198:199], v216 offset:3200
    ds_read_b64_tr_b16 v[200:201], v216 offset:4096
    ds_read_b64_tr_b16 v[202:203], v216 offset:4224
    ds_read_b64_tr_b16 v[204:205], v216 offset:5120
    ds_read_b64_tr_b16 v[206:207], v216 offset:5248
    s_cmp_lg_u32 s32, 0
    s_cbranch_scc1 D_NOH
POLL_B2:
    global_load_dword v96, v29, s[26:27] offset:0 sc1
    global_load_dword v97, v29, s[26:27] offset:128 sc1
    global_load_dword v98, v29, s[26:27] offset:256 sc1
    global_load_dword v99, v29, s[26:27] offset:384 sc1
    global_load_dword v100, v29, s[26:27] offset:512 sc1
    global_load_dword v101, v29, s[26:27] offset:640 sc1
    global_load_dword v102, v29, s[26:27] offset:768 sc1
    global_load_dword v103, v29, s[26:27] offset:896 sc1
    s_add_u32 s41, s41, 1
    s_cmp_gt_u32 s41, 0x40000
    s_cbranch_scc1 DONE
    s_waitcnt vmcnt(0)
    v_xor_b32 v96, v3, v96
    v_xor_b32 v97, v3, v97
    v_xor_b32 v98, v3, v98
    v_xor_b32 v99, v3, v99
    v_xor_b32 v100, v3, v100
    v_xor_b32 v101, v3, v101
    v_xor_b32 v102, v3, v102
    v_xor_b32 v103, v3, v103
    v_or3_b32 v22, v96, v97, v98
    v_or3_b32 v23, v99, v100, v101
    v_or3_b32 v22, v22, v102, v103
    v_bitop3_b32 v22, v22, v23, s58 bitop3:0xa8
    v_cmp_ne_u32 vcc, 0, v22
    s_cbranch_vccnz POLL_B2
    v_pk_add_f32 v[96:97], v[96:97], v[98:99]
    v_pk_add_f32 v[100:101], v[100:101], v[102:103]
    v_pk_add_f32 v[96:97], v[96:97], v[100:101]
    v_add_f32 v16, v96, v97
    v_cvt_pk_bf16_f32 v16, v16, v16
    v_and_b32 v16, 0xffff0000, v16
    v_add_f32 v16, v15, v16
    v_cvt_pk_bf16_f32 v16, v16, v16
    v_and_b32 v15, 0xffff0000, v16
D_NOH:
    s_mov_b32 exec_hi, s47
POLL_C:
    global_load_dwordx4 v[96:99], v13, s[26:27] sc1
    s_add_u32 s41, s41, 1
    s_cmp_gt_u32 s41, 0x40000
    s_cbranch_scc1 DONE
    s_waitcnt vmcnt(0)
    v_xor_b32 v96, v14, v96
    v_xor_b32 v97, v14, v97
    v_xor_b32 v98, v14, v98
    v_xor_b32 v99, v14, v99
    v_or3_b32 v22, v96, v97, v98
    v_bitop3_b32 v22, v22, v99, s46 bitop3:0xa8
    v_cmp_ne_u32 vcc, 0, v22
    s_cbranch_vccnz POLL_C
    v_perm_b32 v16, v97, v96, s42
    v_perm_b32 v17, v99, v98, s42
    ds_write_b64 v8, v[16:17]
    s_mov_b32 exec_hi, -1
    s_waitcnt lgkmcnt(0)
    ds_read_b128 v[32:35], v9 offset:0
    ds_read_b128 v[36:39], v9 offset:64
    ds_read_b128 v[40:43], v9 offset:128
    ds_read_b128 v[44:47], v9 offset:192
    ds_read_b128 v[48:51], v9 offset:256
    ds_read_b128 v[52:55], v9 offset:320
    s_waitcnt lgkmcnt(5)
    v_mfma_f32_16x16x32_bf16 v[244:247], v[32:35], v[184:187], 0
    s_waitcnt lgkmcnt(4)
    v_mfma_f32_16x16x32_bf16 v[244:247], v[36:39], v[188:191], v[244:247]
    s_waitcnt lgkmcnt(3)
TWD0:
    s_cbranch_execz TWD1
    v_mfma_f32_16x16x32_bf16 v[244:247], v[40:43], v[192:195], v[244:247]
    s_waitcnt lgkmcnt(2)
    v_mfma_f32_16x16x32_bf16 v[244:247], v[44:47], v[196:199], v[244:247]
    s_waitcnt lgkmcnt(1)
    v_mfma_f32_16x16x32_bf16 v[244:247], v[48:51], v[200:203], v[244:247]
    s_cmp_ge_u32 s32, 3
    s_cbranch_scc1 D_6
    s_waitcnt lgkmcnt(0)
    v_mfma_f32_16x16x32_bf16 v[244:247], v[52:55], v[204:207], v[244:247]
D_6:
    s_mov_b64 exec, 0xffff
    s_nop 6
    ds_write_b32 v27, v244
    s_mov_b64 exec, -1
    s_waitcnt lgkmcnt(0)
    s_barrier
    s_cmp_lg_u32 s32, 0
    s_cbranch_scc1 DONE
    ds_read_b128 v[32:35], v28 offset:15616
    s_waitcnt lgkmcnt(0)
    v_pk_add_f32 v[32:33], v[32:33], v[34:35]
    v_add_f32 v32, v32, v33
    s_nop 1
    v_add_f32_dpp v16, v32, v32 quad_perm:[1,0,3,2] row_mask:0xf bank_mask:0xf
    v_cvt_pk_bf16_f32 v16, v16, v16
    v_and_b32 v16, 0xffff0000, v16
    v_add_f32 v16, v16, v15
    v_cvt_pk_bf16_f32 v16, v16, v16
    s_mov_b64 exec, 0x55555555
    global_store_short v31, v16, s[22:23]
TWD1:
    s_cbranch_execz TWDR
    s_cmp_lg_u32 s35, 0
    s_cbranch_scc1 DONE
    s_mov_b64 exec, 1
    v_mov_b32 v20, 524032
    v_mov_b32 v21, s59
    global_store_dword v20, v21, s[26:27]
DONE:
    s_waitcnt vmcnt(0)
EXIT:
    s_endpgm
.section .rodata,"a"
.p2align 6
.amdhsa_kernel sequential_preLN__sliding_block_cached__glu_gated_reglu__decode_kernel
  .amdhsa_next_free_vgpr 256
  .amdhsa_next_free_sgpr 96
  .amdhsa_accum_offset 256
  .amdhsa_group_segment_fixed_size 0
  .amdhsa_kernarg_size 96
  .amdhsa_user_sgpr_count 2
  .amdhsa_user_sgpr_kernarg_segment_ptr 1
  .amdhsa_system_sgpr_workgroup_id_x 1
.end_amdhsa_kernel
```
